```python
import torch

def _softmax(x, axis=-1):
    return torch.softmax(x, dim=axis)
def _gelu(x):
    return torch.nn.functional.gelu(x, approximate="tanh")
def _silu(x):
    return torch.nn.functional.silu(x)
def _sigmoid(x):
    return torch.sigmoid(x)
def _layernorm(x, axis=-1, eps=1e-5):
    m = x.mean(dim=axis, keepdim=True)
    v = x.var(dim=axis, keepdim=True, unbiased=False)
    return (x - m) / torch.sqrt(v + eps)
def _scatter_add(tgt, idx, src, axis=0):
    return tgt.clone().index_add_(axis, idx, src)
def _segment_sum(src, seg, n):
    out = torch.zeros((n,) + src.shape[1:], dtype=src.dtype)
    return out.index_add_(0, seg, src)
def _pad(x, pw):
    flat = tuple(v for pair in reversed(pw) for v in pair)
    return torch.nn.functional.pad(x, flat)

kernel_name = 'standalone__gqa_block_cached__decode'

def setup_inputs():

    _w = (lambda a: (lambda t: t.to(torch.bfloat16) if t.is_floating_point() else t)(torch.as_tensor(a)))
    B, Sq, D = 1, 1, 448
    Hq, Hkv, Sk, Dh = 16, 8, 8192, 256
    assert Hq % Hkv == 0, (Hq, Hkv)
    return {
        "x": _w((lambda *s: torch.randn(*s, dtype=torch.bfloat16) * 0.8)(B, Sq, D)),
        "k_cache": _w((lambda *s: torch.randn(*s, dtype=torch.bfloat16) * 0.8)(B, Hkv, Sk, Dh)),
        "v_cache": _w((lambda *s: torch.randn(*s, dtype=torch.bfloat16) * 0.05)(B, Hkv, Sk, Dh)),
        "wq": _w((lambda *s: torch.randn(*s, dtype=torch.bfloat16) * 0.8)(D, Hq * Dh) * (D ** -0.5)),
        "wo": _w((lambda *s: torch.randn(*s, dtype=torch.bfloat16) * 0.05)(Hq * Dh, D) * ((Hq * Dh) ** -0.5)),
    }

def reference(x, k_cache, v_cache, wq, wo):
    B, Sq, D = x.shape
    Hq, Dh = 16, 256
    Hkv = k_cache.shape[1]
    rep = Hq // Hkv
    q = (lambda x, *d: x.permute(*d))((x @ wq).reshape(B, Sq, Hq, Dh), 0, 2, 1, 3)
    k = (lambda x, n, axis: torch.repeat_interleave(x, n, dim=axis))(k_cache, rep, axis=1)
    v = (lambda x, n, axis: torch.repeat_interleave(x, n, dim=axis))(v_cache, rep, axis=1)
    scores = torch.einsum("bhqd,bhkd->bhqk", q, k) * (Dh ** -0.5)
    p = _softmax(scores, axis=-1)
    o = torch.einsum("bhqk,bhkd->bhqd", p, v)
    return (lambda x, *d: x.permute(*d))(o, 0, 2, 1, 3).reshape(B, Sq, Hq * Dh) @ wo
```

```asm
; @launch grid=(256,1,1) block=(512,1,1) lds=37888
.amdgcn_target "amdgcn-amd-amdhsa--gfx950"
.text
.globl standalone__gqa_block_cached__decode_kernel
.p2align 8
.type standalone__gqa_block_cached__decode_kernel,@function
standalone__gqa_block_cached__decode_kernel:
s_cmp_ge_u32 s2, 256
s_cbranch_scc1 L_done
s_load_dwordx16 s[4:19], s[0:1], 0
v_and_b32 v1, 63, v0
v_lshrrev_b32 v2, 6, v0
s_and_b32 s48, s2, 7
s_lshr_b32 s49, s2, 3
v_readfirstlane_b32 s3, v2
v_lshrrev_b32 v7, 4, v1
v_and_b32 v10, 3, v1
v_bfe_u32 v16, v1, 2, 1
s_lshl_b32 s52, s48, 22
s_lshl_b32 s0, s49, 17
s_add_u32 s52, s52, s0
s_and_b32 s0, s3, 3
s_lshl_b32 s0, s0, 15
s_add_u32 s52, s52, s0
s_add_u32 s53, s52, 4096
s_add_u32 s54, s52, 8192
s_add_u32 s55, s52, 12288
s_add_u32 s56, s52, 16384
s_add_u32 s57, s52, 20480
s_add_u32 s58, s52, 24576
s_add_u32 s59, s52, 28672
v_mov_b32 v22, 1024
v_lshlrev_b32 v14, 4, v1
v_mov_b32 v24, 0
v_mov_b32 v25, 0
v_mov_b32 v26, 0
v_mov_b32 v27, 0
s_cmp_lt_u32 s3, 4
s_cbranch_scc1 L_vwave
v_lshlrev_b32 v2, 6, v7
v_bfe_u32 v8, v1, 2, 2
v_lshl_add_u32 v2, v8, 9, v2
v_lshl_add_u32 v2, v10, 4, v2
s_waitcnt lgkmcnt(0)
s_mov_b32 s20, s6
s_mov_b32 s21, s7
s_mov_b32 s22, 33554432
s_mov_b32 s23, 0x20000
buffer_load_dwordx4 v[64:67], v2, s[20:23], s52 offen offset:0 nt
buffer_load_dwordx4 v[68:71], v2, s[20:23], s52 offen offset:256 nt
buffer_load_dwordx4 v[72:75], v2, s[20:23], s52 offen offset:2048 nt
buffer_load_dwordx4 v[76:79], v2, s[20:23], s52 offen offset:2304 nt
buffer_load_dwordx4 v[80:83], v2, s[20:23], s53 offen offset:0 nt
s_barrier
buffer_load_dwordx4 v[84:87], v2, s[20:23], s53 offen offset:256 nt
buffer_load_dwordx4 v[88:91], v2, s[20:23], s53 offen offset:2048 nt
buffer_load_dwordx4 v[92:95], v2, s[20:23], s53 offen offset:2304 nt
buffer_load_dwordx4 v[96:99], v2, s[20:23], s54 offen offset:0 nt
buffer_load_dwordx4 v[100:103], v2, s[20:23], s54 offen offset:256 nt
s_load_dword s50, s[18:19], 0
s_getreg_b32 s62, hwreg(HW_REG_XCC_ID)
s_and_b32 s62, s62, 7
s_mov_b32 s36, s12
s_mov_b32 s37, s13
s_mov_b32 s38, 3670016
s_mov_b32 s39, 0x20000
s_mov_b32 s40, s18
s_mov_b32 s41, s19
s_mov_b32 s42, 8388608
s_mov_b32 s43, 0x20000
s_mov_b32 s44, s14
s_mov_b32 s45, s15
s_mov_b32 s46, 896
s_mov_b32 s47, 0x20000
s_mov_b32 s101, 0x3db8aa3b
s_waitcnt vmcnt(9)
buffer_load_dwordx4 v[104:107], v2, s[20:23], s54 offen offset:2048 nt
s_waitcnt vmcnt(9)
buffer_load_dwordx4 v[108:111], v2, s[20:23], s54 offen offset:2304 nt
s_waitcnt vmcnt(9)
buffer_load_dwordx4 v[112:115], v2, s[20:23], s55 offen offset:0 nt
s_waitcnt vmcnt(9)
buffer_load_dwordx4 v[116:119], v2, s[20:23], s55 offen offset:256 nt
s_waitcnt vmcnt(9)
buffer_load_dwordx4 v[120:123], v2, s[20:23], s55 offen offset:2048 nt
s_waitcnt vmcnt(9)
buffer_load_dwordx4 v[124:127], v2, s[20:23], s55 offen offset:2304 nt
s_waitcnt vmcnt(9)
buffer_load_dwordx4 v[128:131], v2, s[20:23], s56 offen offset:0 nt
s_waitcnt vmcnt(9)
buffer_load_dwordx4 v[132:135], v2, s[20:23], s56 offen offset:256 nt
s_waitcnt vmcnt(9)
buffer_load_dwordx4 v[136:139], v2, s[20:23], s56 offen offset:2048 nt
s_waitcnt vmcnt(9)
buffer_load_dwordx4 v[140:143], v2, s[20:23], s56 offen offset:2304 nt
s_waitcnt vmcnt(9)
buffer_load_dwordx4 v[144:147], v2, s[20:23], s57 offen offset:0 nt
s_waitcnt vmcnt(9)
buffer_load_dwordx4 v[148:151], v2, s[20:23], s57 offen offset:256 nt
s_waitcnt vmcnt(9)
buffer_load_dwordx4 v[152:155], v2, s[20:23], s57 offen offset:2048 nt
s_waitcnt vmcnt(9)
buffer_load_dwordx4 v[156:159], v2, s[20:23], s57 offen offset:2304 nt
s_waitcnt vmcnt(9)
buffer_load_dwordx4 v[160:163], v2, s[20:23], s58 offen offset:0 nt
s_waitcnt vmcnt(9)
buffer_load_dwordx4 v[164:167], v2, s[20:23], s58 offen offset:256 nt
s_waitcnt vmcnt(9)
buffer_load_dwordx4 v[168:171], v2, s[20:23], s58 offen offset:2048 nt
s_waitcnt vmcnt(9)
buffer_load_dwordx4 v[172:175], v2, s[20:23], s58 offen offset:2304 nt
s_waitcnt vmcnt(9)
buffer_load_dwordx4 v[176:179], v2, s[20:23], s59 offen offset:0 nt
s_waitcnt vmcnt(9)
buffer_load_dwordx4 v[180:183], v2, s[20:23], s59 offen offset:256 nt
s_waitcnt vmcnt(9)
buffer_load_dwordx4 v[184:187], v2, s[20:23], s59 offen offset:2048 nt
s_waitcnt vmcnt(9)
buffer_load_dwordx4 v[188:191], v2, s[20:23], s59 offen offset:2304 nt
s_waitcnt lgkmcnt(0)
s_add_u32 s50, s50, 1
s_xor_b32 s51, s50, 0x0a3c96e1
s_lshl_b32 s51, s51, 3
s_or_b32 s63, s51, s62
s_lshl_b32 s0, s48, 14
s_and_b32 s1, s3, 3
s_lshl_b32 s1, s1, 10
s_add_u32 s0, s0, s1
s_add_u32 s98, s0, 262144
v_add_u32 v15, 4096, v14
v_add_u32 v17, 0x2000, v14
v_add_u32 v18, 0x3000, v14
buffer_load_dwordx4 v[192:195], v14, s[40:43], s98 offen sc1
buffer_load_dwordx4 v[196:199], v15, s[40:43], s98 offen sc1
buffer_load_dwordx4 v[200:203], v17, s[40:43], s98 offen sc1
buffer_load_dwordx4 v[204:207], v18, s[40:43], s98 offen sc1
s_barrier
s_mov_b32 s100, 1000000
s_waitcnt vmcnt(0)
L_qchk:
v_xor_b32 v208, s63, v193
v_xor_b32 v209, s63, v195
v_xor_b32 v210, s63, v197
v_xor_b32 v211, s63, v199
v_xor_b32 v212, s63, v201
v_xor_b32 v213, s63, v203
v_xor_b32 v214, s63, v205
v_xor_b32 v215, s63, v207
v_or3_b32 v208, v208, v209, v210
v_or3_b32 v211, v211, v212, v213
v_or3_b32 v208, v208, v214, v215
v_or_b32 v208, v208, v211
v_cmp_le_u32 vcc, 8, v208
s_cbranch_vccz L_qok
s_sub_u32 s100, s100, 1
s_cmp_eq_u32 s100, 0
s_cbranch_scc1 L_qok
s_xor_b32 s98, s98, 131072
s_setprio 3
buffer_load_dwordx4 v[192:195], v14, s[40:43], s98 offen sc1
buffer_load_dwordx4 v[196:199], v15, s[40:43], s98 offen sc1
buffer_load_dwordx4 v[200:203], v17, s[40:43], s98 offen sc1
buffer_load_dwordx4 v[204:207], v18, s[40:43], s98 offen sc1
s_setprio 0
s_waitcnt vmcnt(0)
s_branch L_qchk
L_qok:
v_cmp_ne_u32 vcc, 0, v208
v_add_f32 v192, v192, v196
v_add_f32 v194, v194, v198
v_add_f32 v200, v200, v204
v_add_f32 v202, v202, v206
v_add_f32 v192, v192, v200
v_add_f32 v194, v194, v202
s_cmp_lg_u64 vcc, 0
s_cselect_b32 s1, 0x101, 1
v_cvt_pk_bf16_f32 v192, v192, v194
s_and_b32 s0, s3, 3
s_lshl_b32 s0, s0, 8
v_lshlrev_b32 v15, 2, v1
v_add_u32 v15, s0, v15
ds_write_b32 v15, v192 offset:18432
v_mov_b32 v21, s1
v_lshlrev_b32 v17, 9, v16
v_lshl_add_u32 v17, v7, 6, v17
v_lshl_add_u32 v17, v10, 4, v17
s_waitcnt lgkmcnt(0)
s_mov_b32 exec_lo, 1
s_mov_b32 exec_hi, 0
ds_add_u32 v22, v21 offset:8
s_mov_b64 exec, -1
s_mov_b32 s100, 1000000
L_w1:
ds_read_b32 v21, v22 offset:8
s_waitcnt lgkmcnt(0)
v_readfirstlane_b32 s62, v21
s_sub_u32 s100, s100, 1
s_cmp_eq_u32 s100, 0
s_cbranch_scc1 L_w1x
s_and_b32 s1, s62, 0xff
s_cmp_lt_u32 s1, 4
s_cbranch_scc1 L_w1
L_w1x:
s_lshr_b32 s62, s62, 8
ds_read_b128 v[224:227], v17 offset:18432
ds_read_b128 v[228:231], v17 offset:18688
s_waitcnt lgkmcnt(0)
v_mfma_f32_16x16x32_bf16 v[192:195], v[64:67], v[224:227], 0
v_mfma_f32_16x16x32_bf16 v[196:199], v[72:75], v[224:227], 0
v_mfma_f32_16x16x32_bf16 v[200:203], v[80:83], v[224:227], 0
v_mfma_f32_16x16x32_bf16 v[204:207], v[88:91], v[224:227], 0
v_mfma_f32_16x16x32_bf16 v[208:211], v[96:99], v[224:227], 0
v_mfma_f32_16x16x32_bf16 v[212:215], v[104:107], v[224:227], 0
v_mfma_f32_16x16x32_bf16 v[216:219], v[112:115], v[224:227], 0
v_mfma_f32_16x16x32_bf16 v[220:223], v[120:123], v[224:227], 0
v_mfma_f32_16x16x32_bf16 v[192:195], v[68:71], v[228:231], v[192:195]
v_mfma_f32_16x16x32_bf16 v[196:199], v[76:79], v[228:231], v[196:199]
v_mfma_f32_16x16x32_bf16 v[200:203], v[84:87], v[228:231], v[200:203]
v_mfma_f32_16x16x32_bf16 v[204:207], v[92:95], v[228:231], v[204:207]
v_mfma_f32_16x16x32_bf16 v[208:211], v[100:103], v[228:231], v[208:211]
v_mfma_f32_16x16x32_bf16 v[212:215], v[108:111], v[228:231], v[212:215]
v_mfma_f32_16x16x32_bf16 v[216:219], v[116:119], v[228:231], v[216:219]
v_mfma_f32_16x16x32_bf16 v[220:223], v[124:127], v[228:231], v[220:223]
s_nop 0
v_mov_b32_dpp v232, v192 quad_perm:[0,0,0,0] row_mask:0xf bank_mask:0xf
v_mov_b32_dpp v233, v196 quad_perm:[0,0,0,0] row_mask:0xf bank_mask:0xf
v_mov_b32_dpp v234, v200 quad_perm:[0,0,0,0] row_mask:0xf bank_mask:0xf
v_mov_b32_dpp v235, v204 quad_perm:[0,0,0,0] row_mask:0xf bank_mask:0xf
v_mov_b32_dpp v236, v208 quad_perm:[0,0,0,0] row_mask:0xf bank_mask:0xf
v_mov_b32_dpp v237, v212 quad_perm:[0,0,0,0] row_mask:0xf bank_mask:0xf
v_mov_b32_dpp v238, v216 quad_perm:[0,0,0,0] row_mask:0xf bank_mask:0xf
v_mov_b32_dpp v239, v220 quad_perm:[0,0,0,0] row_mask:0xf bank_mask:0xf
v_add_f32_dpp v232, v193, v232 quad_perm:[1,1,1,1] row_mask:0xf bank_mask:0xf
v_add_f32_dpp v233, v197, v233 quad_perm:[1,1,1,1] row_mask:0xf bank_mask:0xf
v_add_f32_dpp v234, v201, v234 quad_perm:[1,1,1,1] row_mask:0xf bank_mask:0xf
v_add_f32_dpp v235, v205, v235 quad_perm:[1,1,1,1] row_mask:0xf bank_mask:0xf
v_add_f32_dpp v236, v209, v236 quad_perm:[1,1,1,1] row_mask:0xf bank_mask:0xf
v_add_f32_dpp v237, v213, v237 quad_perm:[1,1,1,1] row_mask:0xf bank_mask:0xf
v_add_f32_dpp v238, v217, v238 quad_perm:[1,1,1,1] row_mask:0xf bank_mask:0xf
v_add_f32_dpp v239, v221, v239 quad_perm:[1,1,1,1] row_mask:0xf bank_mask:0xf
v_add_f32_dpp v232, v194, v232 quad_perm:[2,2,2,2] row_mask:0xf bank_mask:0xf
v_add_f32_dpp v233, v198, v233 quad_perm:[2,2,2,2] row_mask:0xf bank_mask:0xf
v_add_f32_dpp v234, v202, v234 quad_perm:[2,2,2,2] row_mask:0xf bank_mask:0xf
v_add_f32_dpp v235, v206, v235 quad_perm:[2,2,2,2] row_mask:0xf bank_mask:0xf
v_add_f32_dpp v236, v210, v236 quad_perm:[2,2,2,2] row_mask:0xf bank_mask:0xf
v_add_f32_dpp v237, v214, v237 quad_perm:[2,2,2,2] row_mask:0xf bank_mask:0xf
v_add_f32_dpp v238, v218, v238 quad_perm:[2,2,2,2] row_mask:0xf bank_mask:0xf
v_add_f32_dpp v239, v222, v239 quad_perm:[2,2,2,2] row_mask:0xf bank_mask:0xf
v_add_f32_dpp v232, v195, v232 quad_perm:[3,3,3,3] row_mask:0xf bank_mask:0xf
v_add_f32_dpp v233, v199, v233 quad_perm:[3,3,3,3] row_mask:0xf bank_mask:0xf
v_add_f32_dpp v234, v203, v234 quad_perm:[3,3,3,3] row_mask:0xf bank_mask:0xf
v_add_f32_dpp v235, v207, v235 quad_perm:[3,3,3,3] row_mask:0xf bank_mask:0xf
v_add_f32_dpp v236, v211, v236 quad_perm:[3,3,3,3] row_mask:0xf bank_mask:0xf
v_add_f32_dpp v237, v215, v237 quad_perm:[3,3,3,3] row_mask:0xf bank_mask:0xf
v_add_f32_dpp v238, v219, v238 quad_perm:[3,3,3,3] row_mask:0xf bank_mask:0xf
v_add_f32_dpp v239, v223, v239 quad_perm:[3,3,3,3] row_mask:0xf bank_mask:0xf
v_mfma_f32_16x16x32_bf16 v[192:195], v[128:131], v[224:227], 0
v_mfma_f32_16x16x32_bf16 v[196:199], v[136:139], v[224:227], 0
v_mfma_f32_16x16x32_bf16 v[200:203], v[144:147], v[224:227], 0
v_mfma_f32_16x16x32_bf16 v[204:207], v[152:155], v[224:227], 0
v_mfma_f32_16x16x32_bf16 v[208:211], v[160:163], v[224:227], 0
v_mfma_f32_16x16x32_bf16 v[212:215], v[168:171], v[224:227], 0
v_mfma_f32_16x16x32_bf16 v[216:219], v[176:179], v[224:227], 0
v_mfma_f32_16x16x32_bf16 v[220:223], v[184:187], v[224:227], 0
v_mfma_f32_16x16x32_bf16 v[192:195], v[132:135], v[228:231], v[192:195]
v_mfma_f32_16x16x32_bf16 v[196:199], v[140:143], v[228:231], v[196:199]
v_mfma_f32_16x16x32_bf16 v[200:203], v[148:151], v[228:231], v[200:203]
v_mfma_f32_16x16x32_bf16 v[204:207], v[156:159], v[228:231], v[204:207]
v_mfma_f32_16x16x32_bf16 v[208:211], v[164:167], v[228:231], v[208:211]
v_mfma_f32_16x16x32_bf16 v[212:215], v[172:175], v[228:231], v[212:215]
v_mfma_f32_16x16x32_bf16 v[216:219], v[180:183], v[228:231], v[216:219]
v_mfma_f32_16x16x32_bf16 v[220:223], v[188:191], v[228:231], v[220:223]
s_nop 0
v_mov_b32_dpp v240, v192 quad_perm:[0,0,0,0] row_mask:0xf bank_mask:0xf
v_mov_b32_dpp v241, v196 quad_perm:[0,0,0,0] row_mask:0xf bank_mask:0xf
v_mov_b32_dpp v242, v200 quad_perm:[0,0,0,0] row_mask:0xf bank_mask:0xf
v_mov_b32_dpp v243, v204 quad_perm:[0,0,0,0] row_mask:0xf bank_mask:0xf
v_mov_b32_dpp v244, v208 quad_perm:[0,0,0,0] row_mask:0xf bank_mask:0xf
v_mov_b32_dpp v245, v212 quad_perm:[0,0,0,0] row_mask:0xf bank_mask:0xf
v_mov_b32_dpp v246, v216 quad_perm:[0,0,0,0] row_mask:0xf bank_mask:0xf
v_mov_b32_dpp v247, v220 quad_perm:[0,0,0,0] row_mask:0xf bank_mask:0xf
v_add_f32_dpp v240, v193, v240 quad_perm:[1,1,1,1] row_mask:0xf bank_mask:0xf
v_add_f32_dpp v241, v197, v241 quad_perm:[1,1,1,1] row_mask:0xf bank_mask:0xf
v_add_f32_dpp v242, v201, v242 quad_perm:[1,1,1,1] row_mask:0xf bank_mask:0xf
v_add_f32_dpp v243, v205, v243 quad_perm:[1,1,1,1] row_mask:0xf bank_mask:0xf
v_add_f32_dpp v244, v209, v244 quad_perm:[1,1,1,1] row_mask:0xf bank_mask:0xf
v_add_f32_dpp v245, v213, v245 quad_perm:[1,1,1,1] row_mask:0xf bank_mask:0xf
v_add_f32_dpp v246, v217, v246 quad_perm:[1,1,1,1] row_mask:0xf bank_mask:0xf
v_add_f32_dpp v247, v221, v247 quad_perm:[1,1,1,1] row_mask:0xf bank_mask:0xf
v_add_f32_dpp v240, v194, v240 quad_perm:[2,2,2,2] row_mask:0xf bank_mask:0xf
v_add_f32_dpp v241, v198, v241 quad_perm:[2,2,2,2] row_mask:0xf bank_mask:0xf
v_add_f32_dpp v242, v202, v242 quad_perm:[2,2,2,2] row_mask:0xf bank_mask:0xf
v_add_f32_dpp v243, v206, v243 quad_perm:[2,2,2,2] row_mask:0xf bank_mask:0xf
v_add_f32_dpp v244, v210, v244 quad_perm:[2,2,2,2] row_mask:0xf bank_mask:0xf
v_add_f32_dpp v245, v214, v245 quad_perm:[2,2,2,2] row_mask:0xf bank_mask:0xf
v_add_f32_dpp v246, v218, v246 quad_perm:[2,2,2,2] row_mask:0xf bank_mask:0xf
v_add_f32_dpp v247, v222, v247 quad_perm:[2,2,2,2] row_mask:0xf bank_mask:0xf
v_add_f32_dpp v240, v195, v240 quad_perm:[3,3,3,3] row_mask:0xf bank_mask:0xf
v_add_f32_dpp v241, v199, v241 quad_perm:[3,3,3,3] row_mask:0xf bank_mask:0xf
v_add_f32_dpp v242, v203, v242 quad_perm:[3,3,3,3] row_mask:0xf bank_mask:0xf
v_add_f32_dpp v243, v207, v243 quad_perm:[3,3,3,3] row_mask:0xf bank_mask:0xf
v_add_f32_dpp v244, v211, v244 quad_perm:[3,3,3,3] row_mask:0xf bank_mask:0xf
v_add_f32_dpp v245, v215, v245 quad_perm:[3,3,3,3] row_mask:0xf bank_mask:0xf
v_add_f32_dpp v246, v219, v246 quad_perm:[3,3,3,3] row_mask:0xf bank_mask:0xf
v_add_f32_dpp v247, v223, v247 quad_perm:[3,3,3,3] row_mask:0xf bank_mask:0xf
v_max3_f32 v248, v232, v233, v234
v_max3_f32 v248, v248, v235, v236
v_max3_f32 v248, v248, v237, v238
v_max3_f32 v248, v248, v239, v240
v_max3_f32 v248, v248, v241, v242
v_max3_f32 v248, v248, v243, v244
v_max3_f32 v248, v248, v245, v246
v_max_f32 v248, v248, v247
v_mov_b32 v249, v248
s_nop 1
v_permlane16_swap_b32 v249, v248
v_max_f32 v248, v248, v249
v_mov_b32 v249, v248
s_nop 1
v_permlane32_swap_b32 v249, v248
v_max_f32 v248, v248, v249
v_mul_f32 v248, s101, v248
v_fma_f32 v232, v232, s101, -v248
v_fma_f32 v233, v233, s101, -v248
v_fma_f32 v234, v234, s101, -v248
v_fma_f32 v235, v235, s101, -v248
v_fma_f32 v236, v236, s101, -v248
v_fma_f32 v237, v237, s101, -v248
v_fma_f32 v238, v238, s101, -v248
v_fma_f32 v239, v239, s101, -v248
v_fma_f32 v240, v240, s101, -v248
v_fma_f32 v241, v241, s101, -v248
v_fma_f32 v242, v242, s101, -v248
v_fma_f32 v243, v243, s101, -v248
v_fma_f32 v244, v244, s101, -v248
v_fma_f32 v245, v245, s101, -v248
v_fma_f32 v246, v246, s101, -v248
v_fma_f32 v247, v247, s101, -v248
v_exp_f32 v232, v232
v_exp_f32 v233, v233
v_exp_f32 v234, v234
v_exp_f32 v235, v235
v_exp_f32 v236, v236
v_exp_f32 v237, v237
v_exp_f32 v238, v238
v_exp_f32 v239, v239
v_exp_f32 v240, v240
v_exp_f32 v241, v241
v_exp_f32 v242, v242
v_exp_f32 v243, v243
v_exp_f32 v244, v244
v_exp_f32 v245, v245
v_exp_f32 v246, v246
v_exp_f32 v247, v247
v_cvt_pk_bf16_f32 v192, v232, v233
v_cvt_pk_bf16_f32 v193, v234, v235
v_cvt_pk_bf16_f32 v194, v236, v237
v_cvt_pk_bf16_f32 v195, v238, v239
v_cvt_pk_bf16_f32 v196, v240, v241
v_cvt_pk_bf16_f32 v197, v242, v243
v_cvt_pk_bf16_f32 v198, v244, v245
v_cvt_pk_bf16_f32 v199, v246, v247
v_mov_b32 v200, 0x3f803f80
v_mov_b32 v201, 0x3f803f80
v_mov_b32 v202, 0x3f803f80
v_mov_b32 v203, 0x3f803f80
s_nop 1
v_mfma_f32_16x16x32_bf16 v[204:207], v[200:203], v[192:195], 0
v_mfma_f32_16x16x32_bf16 v[204:207], v[200:203], v[196:199], v[204:207]
s_and_b32 s0, s3, 3
s_lshl_b32 s1, s0, 11
v_add_u32 v20, s1, v14
ds_write_b128 v20, v[192:195] offset:2048
ds_write_b128 v20, v[196:199] offset:3072
s_lshl_b32 s1, s0, 2
v_lshlrev_b32 v18, 4, v16
v_add_u32 v19, s1, v18
s_mov_b32 exec_lo, 0x11
s_mov_b32 exec_hi, 0
ds_write_b32 v19, v248 offset:1088
ds_write_b32 v19, v204 offset:1152
s_mov_b64 exec, -1
v_mov_b32 v21, 1
s_waitcnt lgkmcnt(0)
s_mov_b32 exec_lo, 1
s_mov_b32 exec_hi, 0
ds_add_u32 v22, v21 offset:16
s_mov_b64 exec, -1
s_cmp_lg_u32 s3, 4
s_cbranch_scc1 L_noeml
s_mov_b32 s100, 1000000
L_w2:
ds_read_b32 v21, v22 offset:16
s_waitcnt lgkmcnt(0)
v_readfirstlane_b32 s0, v21
s_sub_u32 s100, s100, 1
s_cmp_eq_u32 s100, 0
s_cbranch_scc1 L_w2x
s_cmp_lt_u32 s0, 4
s_cbranch_scc1 L_w2
L_w2x:
ds_read_b128 v[232:235], v18 offset:1088
ds_read_b128 v[236:239], v18 offset:1152
s_waitcnt lgkmcnt(0)
v_max3_f32 v241, v232, v233, v234
v_max_f32 v241, v241, v235
v_sub_f32 v232, v232, v241
v_sub_f32 v233, v233, v241
v_sub_f32 v234, v234, v241
v_sub_f32 v235, v235, v241
v_exp_f32 v232, v232
v_exp_f32 v233, v233
v_exp_f32 v234, v234
v_exp_f32 v235, v235
v_mul_f32 v242, v232, v236
v_fmac_f32 v242, v233, v237
v_fmac_f32 v242, v234, v238
v_fmac_f32 v242, v235, v239
v_mov_b32 v192, v241
v_mov_b32 v193, s51
v_mov_b32 v194, v242
v_mov_b32 v195, s51
v_lshlrev_b32 v8, 9, v16
s_lshl_b32 s1, s48, 10
s_lshl_b32 s0, s49, 4
s_add_u32 s1, s1, s0
s_add_u32 s1, s1, 24576
s_mov_b32 exec_lo, 0x11
s_mov_b32 exec_hi, 0
s_cmp_lg_u32 s62, 0
s_cbranch_scc1 L_s3a
buffer_store_dwordx4 v[192:195], v8, s[40:43], s1 offen
s_branch L_s3b
L_s3a:
buffer_store_dwordx4 v[192:195], v8, s[40:43], s1 offen sc1
L_s3b:
s_mov_b64 exec, -1
L_noeml:
s_branch L_join
L_vwave:
s_lshr_b32 s0, s49, 3
s_mul_i32 s0, s0, 112
s_mul_i32 s1, s3, 28
s_add_u32 s0, s0, s1
s_lshl_b32 s1, s0, 1
v_lshlrev_b32 v6, 2, v1
v_add_u32 v6, s1, v6
v_mov_b32 v9, 0x10000000
v_cmp_gt_u32 vcc, 14, v1
s_nop 1
v_cndmask_b32 v6, v9, v6, vcc
v_lshrrev_b32 v8, 3, v1
v_add_u32 v4, s0, v8
s_lshl_b32 s0, s48, 10
s_and_b32 s1, s49, 7
s_lshl_b32 s1, s1, 7
s_add_u32 s0, s0, s1
v_and_b32 v11, 7, v1
v_lshlrev_b32 v12, 4, v11
v_lshl_add_u32 v4, v4, 13, v12
v_add_u32 v4, s0, v4
v_add_u32 v13, 0x30000, v4
v_cmp_gt_u32 vcc, 32, v1
s_nop 1
v_cndmask_b32 v13, v9, v13, vcc
v_add_u32 v5, 0x10000, v4
v_add_u32 v15, 0x20000, v4
ds_write_b128 v22, v[24:27]
ds_write_b128 v22, v[24:27] offset:16
s_waitcnt lgkmcnt(0)
s_mov_b32 s28, s10
s_mov_b32 s29, s11
s_mov_b32 s30, 3670016
s_mov_b32 s31, 0x20000
s_mov_b32 s32, s4
s_mov_b32 s33, s5
s_mov_b32 s34, 896
s_mov_b32 s35, 0x20000
buffer_load_dword v128, v6, s[32:35], 0 offen
buffer_load_dwordx4 v[132:135], v4, s[28:31], 0 offen nt
buffer_load_dwordx4 v[136:139], v5, s[28:31], 0 offen nt
buffer_load_dwordx4 v[140:143], v15, s[28:31], 0 offen nt
buffer_load_dwordx4 v[144:147], v13, s[28:31], 0 offen nt
s_barrier
s_load_dword s50, s[18:19], 0
s_getreg_b32 s62, hwreg(HW_REG_XCC_ID)
s_and_b32 s62, s62, 7
s_mov_b32 s36, s12
s_mov_b32 s37, s13
s_mov_b32 s38, 3670016
s_mov_b32 s39, 0x20000
s_mov_b32 s40, s18
s_mov_b32 s41, s19
s_mov_b32 s42, 8388608
s_mov_b32 s43, 0x20000
s_mov_b32 s44, s14
s_mov_b32 s45, s15
s_mov_b32 s46, 896
s_mov_b32 s47, 0x20000
s_mov_b32 s101, 0x3db8aa3b
s_mov_b32 s24, s8
s_mov_b32 s25, s9
s_mov_b32 s26, 33554432
s_mov_b32 s27, 0x20000
s_mov_b32 s60, 0x05040100
s_mov_b32 s61, 0x07060302
s_mov_b32 s64, 0x110011
s_mov_b32 s65, 0x110011
s_mov_b32 s66, 0x220022
s_mov_b32 s67, 0x220022
s_mov_b32 s68, 0x440044
s_mov_b32 s69, 0x440044
s_mov_b32 s70, 0x880088
s_mov_b32 s71, 0x880088
s_mov_b32 s72, 0x11001100
s_mov_b32 s73, 0x11001100
s_mov_b32 s74, 0x22002200
s_mov_b32 s75, 0x22002200
s_mov_b32 s76, 0x44004400
s_mov_b32 s77, 0x44004400
s_mov_b32 s78, 0x88008800
s_mov_b32 s79, 0x88008800
v_and_b32 v9, 15, v1
v_lshlrev_b32 v3, 9, v7
v_lshl_add_u32 v3, v9, 4, v3
v_and_b32 v12, 1, v8
v_lshlrev_b32 v12, 4, v12
v_sub_u32 v12, 16, v12
v_lshlrev_b32 v8, 2, v7
v_lshlrev_b32 v11, 5, v11
v_lshl_add_u32 v11, v7, 8, v11
s_lshl_b32 s0, s3, 10
v_add_u32 v11, s0, v11
s_waitcnt vmcnt(4)
ds_bpermute_b32 v148, v8, v128
v_add_u32 v9, 16, v8
ds_bpermute_b32 v149, v9, v128
v_add_u32 v9, 32, v8
ds_bpermute_b32 v150, v9, v128
v_add_u32 v9, 48, v8
ds_bpermute_b32 v151, v9, v128
s_waitcnt lgkmcnt(0)
s_add_u32 s50, s50, 1
s_xor_b32 s51, s50, 0x0a3c96e1
s_lshl_b32 s51, s51, 3
s_or_b32 s63, s51, s62
v_lshlrev_b32 v148, v12, v148
v_and_b32 v148, 0xffff0000, v148
v_lshlrev_b32 v149, v12, v149
v_and_b32 v149, 0xffff0000, v149
v_lshlrev_b32 v150, v12, v150
v_and_b32 v150, 0xffff0000, v150
v_lshlrev_b32 v151, v12, v151
v_and_b32 v151, 0xffff0000, v151
s_waitcnt vmcnt(3)
v_lshlrev_b32 v160, 16, v132
v_and_b32 v161, 0xffff0000, v132
v_mul_f32 v152, v160, v148
v_mul_f32 v153, v161, v148
v_lshlrev_b32 v160, 16, v133
v_and_b32 v161, 0xffff0000, v133
v_mul_f32 v154, v160, v148
v_mul_f32 v155, v161, v148
v_lshlrev_b32 v160, 16, v134
v_and_b32 v161, 0xffff0000, v134
v_mul_f32 v156, v160, v148
v_mul_f32 v157, v161, v148
v_lshlrev_b32 v160, 16, v135
v_and_b32 v161, 0xffff0000, v135
v_mul_f32 v158, v160, v148
v_mul_f32 v159, v161, v148
s_waitcnt vmcnt(2)
v_lshlrev_b32 v160, 16, v136
v_and_b32 v161, 0xffff0000, v136
v_fmac_f32 v152, v160, v149
v_fmac_f32 v153, v161, v149
v_lshlrev_b32 v160, 16, v137
v_and_b32 v161, 0xffff0000, v137
v_fmac_f32 v154, v160, v149
v_fmac_f32 v155, v161, v149
v_lshlrev_b32 v160, 16, v138
v_and_b32 v161, 0xffff0000, v138
v_fmac_f32 v156, v160, v149
v_fmac_f32 v157, v161, v149
v_lshlrev_b32 v160, 16, v139
v_and_b32 v161, 0xffff0000, v139
v_fmac_f32 v158, v160, v149
v_fmac_f32 v159, v161, v149
s_waitcnt vmcnt(1)
v_lshlrev_b32 v160, 16, v140
v_and_b32 v161, 0xffff0000, v140
v_fmac_f32 v152, v160, v150
v_fmac_f32 v153, v161, v150
v_lshlrev_b32 v160, 16, v141
v_and_b32 v161, 0xffff0000, v141
v_fmac_f32 v154, v160, v150
v_fmac_f32 v155, v161, v150
v_lshlrev_b32 v160, 16, v142
v_and_b32 v161, 0xffff0000, v142
v_fmac_f32 v156, v160, v150
v_fmac_f32 v157, v161, v150
v_lshlrev_b32 v160, 16, v143
v_and_b32 v161, 0xffff0000, v143
v_fmac_f32 v158, v160, v150
v_fmac_f32 v159, v161, v150
s_waitcnt vmcnt(0)
v_lshlrev_b32 v160, 16, v144
v_and_b32 v161, 0xffff0000, v144
v_fmac_f32 v152, v160, v151
v_fmac_f32 v153, v161, v151
v_lshlrev_b32 v160, 16, v145
v_and_b32 v161, 0xffff0000, v145
v_fmac_f32 v154, v160, v151
v_fmac_f32 v155, v161, v151
v_lshlrev_b32 v160, 16, v146
v_and_b32 v161, 0xffff0000, v146
v_fmac_f32 v156, v160, v151
v_fmac_f32 v157, v161, v151
v_lshlrev_b32 v160, 16, v147
v_and_b32 v161, 0xffff0000, v147
v_fmac_f32 v158, v160, v151
v_fmac_f32 v159, v161, v151
v_add_f32_dpp v152, v152, v152 row_ror:8 row_mask:0xf bank_mask:0xf
v_add_f32_dpp v153, v153, v153 row_ror:8 row_mask:0xf bank_mask:0xf
v_add_f32_dpp v154, v154, v154 row_ror:8 row_mask:0xf bank_mask:0xf
v_add_f32_dpp v155, v155, v155 row_ror:8 row_mask:0xf bank_mask:0xf
v_add_f32_dpp v156, v156, v156 row_ror:8 row_mask:0xf bank_mask:0xf
v_add_f32_dpp v157, v157, v157 row_ror:8 row_mask:0xf bank_mask:0xf
v_add_f32_dpp v158, v158, v158 row_ror:8 row_mask:0xf bank_mask:0xf
v_add_f32_dpp v159, v159, v159 row_ror:8 row_mask:0xf bank_mask:0xf
s_mov_b32 exec_lo, 0x00ff00ff
s_mov_b32 exec_hi, 0x00ff00ff
ds_write_b128 v11, v[152:155] offset:33792
ds_write_b128 v11, v[156:159] offset:33808
s_mov_b64 exec, -1
v_mov_b32 v21, 1
s_waitcnt lgkmcnt(0)
s_mov_b32 exec_lo, 1
s_mov_b32 exec_hi, 0
ds_add_u32 v22, v21 offset:0
s_mov_b64 exec, -1
s_cmp_lg_u32 s3, 0
s_cbranch_scc1 L_noq
v_lshlrev_b32 v12, 2, v1
v_lshlrev_b32 v13, 3, v1
s_lshl_b32 s0, s48, 14
s_lshr_b32 s1, s49, 3
s_lshl_b32 s1, s1, 12
s_add_u32 s60, s0, s1
s_and_b32 s1, s49, 7
s_lshl_b32 s1, s1, 9
s_add_u32 s60, s60, s1
s_mov_b32 s100, 1000000
L_w4:
ds_read_b32 v21, v22 offset:0
s_waitcnt lgkmcnt(0)
v_readfirstlane_b32 s0, v21
s_sub_u32 s100, s100, 1
s_cmp_eq_u32 s100, 0
s_cbranch_scc1 L_w4x
s_cmp_lt_u32 s0, 4
s_cbranch_scc1 L_w4
L_w4x:
ds_read_b32 v144, v12 offset:33792
ds_read_b32 v145, v12 offset:34048
ds_read_b32 v146, v12 offset:34304
ds_read_b32 v147, v12 offset:34560
ds_read_b32 v148, v12 offset:34816
ds_read_b32 v149, v12 offset:35072
ds_read_b32 v150, v12 offset:35328
ds_read_b32 v151, v12 offset:35584
ds_read_b32 v152, v12 offset:35840
ds_read_b32 v153, v12 offset:36096
ds_read_b32 v154, v12 offset:36352
ds_read_b32 v155, v12 offset:36608
ds_read_b32 v156, v12 offset:36864
ds_read_b32 v157, v12 offset:37120
ds_read_b32 v158, v12 offset:37376
ds_read_b32 v159, v12 offset:37632
s_add_u32 s1, s60, 393216
s_add_u32 s0, s60, 262144
s_mov_b32 s60, 0x05040100
s_waitcnt lgkmcnt(0)
v_add_f32 v144, v144, v145
v_add_f32 v146, v146, v147
v_add_f32 v148, v148, v149
v_add_f32 v150, v150, v151
v_add_f32 v152, v152, v153
v_add_f32 v154, v154, v155
v_add_f32 v156, v156, v157
v_add_f32 v158, v158, v159
v_add_f32 v144, v144, v146
v_add_f32 v148, v148, v150
v_add_f32 v152, v152, v154
v_add_f32 v156, v156, v158
v_add_f32 v144, v144, v148
v_add_f32 v152, v152, v156
v_add_f32 v144, v144, v152
s_nop 1
v_mov_b32_dpp v146, v144 quad_perm:[1,0,3,2] row_mask:0xf bank_mask:0xf
v_mov_b32 v145, s63
v_mov_b32 v147, s63
s_mov_b32 exec_lo, 0x55555555
s_mov_b32 exec_hi, 0x55555555
buffer_store_dwordx4 v[144:147], v13, s[40:43], s0 offen
buffer_store_dwordx4 v[144:147], v13, s[40:43], s1 offen sc1
s_mov_b64 exec, -1
L_noq:
s_barrier
buffer_load_dwordx4 v[64:67], v3, s[24:27], s52 offen offset:0 nt
buffer_load_dwordx4 v[68:71], v3, s[24:27], s52 offen offset:2048 nt
buffer_load_dwordx4 v[72:75], v3, s[24:27], s53 offen offset:0 nt
buffer_load_dwordx4 v[76:79], v3, s[24:27], s53 offen offset:2048 nt
buffer_load_dwordx4 v[80:83], v3, s[24:27], s54 offen offset:0 nt
buffer_load_dwordx4 v[84:87], v3, s[24:27], s54 offen offset:2048 nt
buffer_load_dwordx4 v[88:91], v3, s[24:27], s55 offen offset:0 nt
buffer_load_dwordx4 v[92:95], v3, s[24:27], s55 offen offset:2048 nt
buffer_load_dwordx4 v[96:99], v3, s[24:27], s52 offen offset:256 nt
buffer_load_dwordx4 v[100:103], v3, s[24:27], s52 offen offset:2304 nt
buffer_load_dwordx4 v[104:107], v3, s[24:27], s53 offen offset:256 nt
buffer_load_dwordx4 v[108:111], v3, s[24:27], s53 offen offset:2304 nt
buffer_load_dwordx4 v[112:115], v3, s[24:27], s54 offen offset:256 nt
buffer_load_dwordx4 v[116:119], v3, s[24:27], s54 offen offset:2304 nt
buffer_load_dwordx4 v[120:123], v3, s[24:27], s55 offen offset:256 nt
buffer_load_dwordx4 v[124:127], v3, s[24:27], s55 offen offset:2304 nt
buffer_load_dwordx4 v[128:131], v3, s[24:27], s56 offen offset:0 nt
buffer_load_dwordx4 v[132:135], v3, s[24:27], s56 offen offset:2048 nt
buffer_load_dwordx4 v[136:139], v3, s[24:27], s57 offen offset:0 nt
buffer_load_dwordx4 v[140:143], v3, s[24:27], s57 offen offset:2048 nt
buffer_load_dwordx4 v[144:147], v3, s[24:27], s58 offen offset:0 nt
buffer_load_dwordx4 v[148:151], v3, s[24:27], s58 offen offset:2048 nt
buffer_load_dwordx4 v[152:155], v3, s[24:27], s59 offen offset:0 nt
buffer_load_dwordx4 v[156:159], v3, s[24:27], s59 offen offset:2048 nt
buffer_load_dwordx4 v[160:163], v3, s[24:27], s56 offen offset:256 nt
buffer_load_dwordx4 v[164:167], v3, s[24:27], s56 offen offset:2304 nt
buffer_load_dwordx4 v[168:171], v3, s[24:27], s57 offen offset:256 nt
buffer_load_dwordx4 v[172:175], v3, s[24:27], s57 offen offset:2304 nt
buffer_load_dwordx4 v[176:179], v3, s[24:27], s58 offen offset:256 nt
buffer_load_dwordx4 v[180:183], v3, s[24:27], s58 offen offset:2304 nt
buffer_load_dwordx4 v[184:187], v3, s[24:27], s59 offen offset:256 nt
buffer_load_dwordx4 v[188:191], v3, s[24:27], s59 offen offset:2304 nt
L_join:
s_waitcnt lgkmcnt(0)
s_barrier
s_cmp_lt_u32 s3, 4
s_cbranch_scc1 L_vpv
s_lshl_b32 s0, s48, 9
s_lshl_b32 s1, s49, 4
s_add_u32 s0, s0, s1
s_and_b32 s1, s3, 3
s_lshl_b32 s1, s1, 2
s_add_u32 s0, s0, s1
s_mul_i32 s0, s0, 896
s_mov_b32 exec_hi, 0x00ffffff
buffer_load_dwordx4 v[64:67], v14, s[36:39], s0 offen offset:0 nt
buffer_load_dwordx4 v[68:71], v14, s[36:39], s0 offen offset:896 nt
buffer_load_dwordx4 v[72:75], v14, s[36:39], s0 offen offset:1792 nt
buffer_load_dwordx4 v[76:79], v14, s[36:39], s0 offen offset:2688 nt
s_mov_b64 exec, -1
s_cmp_lg_u32 s3, 6
s_cbranch_scc1 L_nopre
s_lshl_b32 s0, s48, 17
s_lshl_b32 s1, s49, 12
s_add_u32 s0, s0, s1
s_add_u32 s0, s0, 1048576
v_lshlrev_b32 v8, 7, v1
s_mov_b32 exec_hi, 0
buffer_load_dword v52, v8, s[40:43], s0 offen sc1
s_mov_b64 exec, -1
L_nopre:
s_cmp_lg_u32 s3, 5
s_cbranch_scc1 L_nopre2
s_cmp_ge_u32 s49, 28
s_cbranch_scc1 L_nopre2
s_mul_i32 s0, s48, 114688
s_lshl_b32 s1, s49, 12
s_add_u32 s0, s0, s1
s_add_u32 s0, s0, 2097152
v_lshlrev_b32 v8, 7, v1
s_mov_b32 exec_hi, 0
buffer_load_dword v52, v8, s[40:43], s0 offen sc1
s_mov_b64 exec, -1
L_nopre2:
s_cmp_lg_u32 s3, 7
s_cbranch_scc1 L_nogp
v_bfe_u32 v8, v1, 1, 4
v_lshlrev_b32 v25, 7, v8
v_lshrrev_b32 v9, 5, v1
v_lshl_add_u32 v25, v9, 6, v25
v_and_b32 v9, 1, v1
v_lshl_add_u32 v25, v9, 5, v25
v_lshlrev_b32 v26, 4, v8
s_lshl_b32 s0, s48, 17
s_lshl_b32 s1, s49, 12
s_add_u32 s0, s0, s1
s_add_u32 s60, s0, 1048576
s_lshl_b32 s1, s48, 1
s_lshr_b32 s0, s49, 4
s_add_u32 s1, s1, s0
s_lshl_b32 s1, s1, 9
s_add_u32 s61, s1, 24576
buffer_load_dwordx4 v[144:147], v26, s[40:43], s61 offen sc1
buffer_load_dwordx4 v[148:151], v26, s[40:43], s61 offen offset:256 sc1
v_lshrrev_b32 v27, 5, v1
v_lshlrev_b32 v27, 5, v27
v_lshl_add_u32 v27, v9, 4, v27
L_nogp:
s_and_b32 s1, s3, 3
s_mul_i32 s1, s1, 3584
v_add_u32 v20, s1, v14
s_barrier
s_cmp_eq_u32 s3, 7
s_cbranch_scc1 L_wo7
s_waitcnt vmcnt(0)
s_branch L_wost
L_wo7:
buffer_load_dwordx4 v[128:131], v25, s[40:43], s60 offen offset:0 sc1
buffer_load_dwordx4 v[132:135], v25, s[40:43], s60 offen offset:16 sc1
buffer_load_dwordx4 v[136:139], v25, s[40:43], s60 offen offset:2048 sc1
buffer_load_dwordx4 v[140:143], v25, s[40:43], s60 offen offset:2064 sc1
s_waitcnt vmcnt(6)
L_wost:
s_mov_b32 exec_hi, 0x00ffffff
ds_write_b128 v20, v[64:67] offset:19456
ds_write_b128 v20, v[68:71] offset:20352
ds_write_b128 v20, v[72:75] offset:21248
ds_write_b128 v20, v[76:79] offset:22144
s_mov_b64 exec, -1
v_mov_b32 v21, 1
s_waitcnt lgkmcnt(0)
s_mov_b32 exec_lo, 1
s_mov_b32 exec_hi, 0
ds_add_u32 v22, v21 offset:12
s_mov_b64 exec, -1
s_cmp_lg_u32 s3, 7
s_cbranch_scc1 L_nob
s_mov_b32 s100, 1000000
s_waitcnt vmcnt(4)
L_mlchk:
v_min3_u32 v152, v145, v147, v149
v_max3_u32 v153, v145, v147, v149
v_min_u32 v152, v152, v151
v_max_u32 v153, v153, v151
v_xor_b32 v152, s51, v152
v_xor_b32 v153, s51, v153
v_or_b32 v152, v152, v153
v_cmp_ne_u32 vcc, 0, v152
s_cbranch_vccz L_mlok
s_sub_u32 s100, s100, 1
s_cmp_eq_u32 s100, 0
s_cbranch_scc1 L_mlok
buffer_load_dwordx4 v[144:147], v26, s[40:43], s61 offen sc1
buffer_load_dwordx4 v[148:151], v26, s[40:43], s61 offen offset:256 sc1
s_waitcnt vmcnt(0)
s_branch L_mlchk
L_mlok:
v_max_f32 v152, v144, v148
s_nop 1
v_max_f32_dpp v152, v152, v152 row_ror:2 row_mask:0xf bank_mask:0xf
s_nop 1
v_max_f32_dpp v152, v152, v152 row_ror:4 row_mask:0xf bank_mask:0xf
s_nop 1
v_max_f32_dpp v152, v152, v152 row_ror:8 row_mask:0xf bank_mask:0xf
v_mov_b32 v153, v152
s_nop 1
v_permlane16_swap_b32 v153, v152
v_max_f32 v152, v152, v153
v_sub_f32 v144, v144, v152
v_sub_f32 v148, v148, v152
v_exp_f32 v144, v144
v_exp_f32 v148, v148
v_mul_f32 v154, v144, v146
v_fmac_f32 v154, v148, v150
s_nop 1
v_add_f32_dpp v154, v154, v154 row_ror:2 row_mask:0xf bank_mask:0xf
s_nop 1
v_add_f32_dpp v154, v154, v154 row_ror:4 row_mask:0xf bank_mask:0xf
s_nop 1
v_add_f32_dpp v154, v154, v154 row_ror:8 row_mask:0xf bank_mask:0xf
v_mov_b32 v155, v154
s_nop 1
v_permlane16_swap_b32 v155, v154
v_add_f32 v154, v154, v155
v_rcp_f32 v154, v154
s_nop 0
v_mul_f32 v144, v144, v154
v_mul_f32 v148, v148, v154
s_mov_b32 s100, 1000000
L_bchk:
buffer_load_dwordx4 v[164:167], v25, s[40:43], s60 offen offset:0 sc1
buffer_load_dwordx4 v[168:171], v25, s[40:43], s60 offen offset:16 sc1
buffer_load_dwordx4 v[172:175], v25, s[40:43], s60 offen offset:2048 sc1
buffer_load_dwordx4 v[176:179], v25, s[40:43], s60 offen offset:2064 sc1
s_waitcnt vmcnt(4)
v_min3_u32 v152, v129, v131, v133
v_max3_u32 v153, v129, v131, v133
v_min3_u32 v152, v152, v135, v137
v_max3_u32 v153, v153, v135, v137
v_min3_u32 v152, v152, v139, v141
v_max3_u32 v153, v153, v139, v141
v_min_u32 v152, v152, v143
v_max_u32 v153, v153, v143
v_mul_f32 v156, v144, v128
v_mul_f32 v157, v144, v130
v_mul_f32 v158, v144, v132
v_mul_f32 v159, v144, v134
v_xor_b32 v152, s51, v152
v_xor_b32 v153, s51, v153
v_or_b32 v152, v152, v153
v_fmac_f32 v156, v148, v136
v_fmac_f32 v157, v148, v138
v_fmac_f32 v158, v148, v140
v_fmac_f32 v159, v148, v142
v_cmp_ne_u32 vcc, 0, v152
s_cbranch_vccz L_bok
buffer_load_dwordx4 v[128:131], v25, s[40:43], s60 offen offset:0 sc1
buffer_load_dwordx4 v[132:135], v25, s[40:43], s60 offen offset:16 sc1
buffer_load_dwordx4 v[136:139], v25, s[40:43], s60 offen offset:2048 sc1
buffer_load_dwordx4 v[140:143], v25, s[40:43], s60 offen offset:2064 sc1
s_waitcnt vmcnt(4)
v_min3_u32 v152, v165, v167, v169
v_max3_u32 v153, v165, v167, v169
v_min3_u32 v152, v152, v171, v173
v_max3_u32 v153, v153, v171, v173
v_min3_u32 v152, v152, v175, v177
v_max3_u32 v153, v153, v175, v177
v_min_u32 v152, v152, v179
v_max_u32 v153, v153, v179
v_mul_f32 v156, v144, v164
v_mul_f32 v157, v144, v166
v_mul_f32 v158, v144, v168
v_mul_f32 v159, v144, v170
v_xor_b32 v152, s51, v152
v_xor_b32 v153, s51, v153
v_or_b32 v152, v152, v153
v_fmac_f32 v156, v148, v172
v_fmac_f32 v157, v148, v174
v_fmac_f32 v158, v148, v176
v_fmac_f32 v159, v148, v178
v_cmp_ne_u32 vcc, 0, v152
s_cbranch_vccz L_bok
s_sub_u32 s100, s100, 1
s_cmp_lg_u32 s100, 0
s_cbranch_scc1 L_bchk
L_bok:
v_add_f32_dpp v156, v156, v156 row_ror:2 row_mask:0xf bank_mask:0xf
v_add_f32_dpp v157, v157, v157 row_ror:2 row_mask:0xf bank_mask:0xf
v_add_f32_dpp v158, v158, v158 row_ror:2 row_mask:0xf bank_mask:0xf
v_add_f32_dpp v159, v159, v159 row_ror:2 row_mask:0xf bank_mask:0xf
v_add_f32_dpp v156, v156, v156 row_ror:4 row_mask:0xf bank_mask:0xf
v_add_f32_dpp v157, v157, v157 row_ror:4 row_mask:0xf bank_mask:0xf
v_add_f32_dpp v158, v158, v158 row_ror:4 row_mask:0xf bank_mask:0xf
v_add_f32_dpp v159, v159, v159 row_ror:4 row_mask:0xf bank_mask:0xf
v_add_f32_dpp v156, v156, v156 row_ror:8 row_mask:0xf bank_mask:0xf
v_add_f32_dpp v157, v157, v157 row_ror:8 row_mask:0xf bank_mask:0xf
v_add_f32_dpp v158, v158, v158 row_ror:8 row_mask:0xf bank_mask:0xf
v_add_f32_dpp v159, v159, v159 row_ror:8 row_mask:0xf bank_mask:0xf
v_mov_b32 v160, v156
v_mov_b32 v161, v157
v_mov_b32 v162, v158
v_mov_b32 v163, v159
v_permlane16_swap_b32 v160, v156
v_permlane16_swap_b32 v161, v157
v_permlane16_swap_b32 v162, v158
v_permlane16_swap_b32 v163, v159
v_add_f32 v156, v156, v160
v_add_f32 v157, v157, v161
v_add_f32 v158, v158, v162
v_add_f32 v159, v159, v163
v_cvt_pk_bf16_f32 v160, v156, v157
v_cvt_pk_bf16_f32 v161, v158, v159
v_lshlrev_b32 v156, 16, v160
v_and_b32 v157, 0xffff0000, v160
v_lshlrev_b32 v158, 16, v161
v_and_b32 v159, 0xffff0000, v161
s_mov_b32 exec_lo, 3
s_mov_b32 exec_hi, 3
ds_write_b128 v27, v[156:159] offset:1216
s_mov_b64 exec, -1
s_branch L_nob
L_vpv:
v_lshlrev_b32 v18, 4, v16
ds_read_b128 v[232:235], v18 offset:1088
ds_read_b128 v[236:239], v18 offset:1152
ds_read_b32 v240, v22 offset:8
s_lshl_b32 s1, s3, 11
v_lshlrev_b32 v20, 4, v1
v_add_u32 v20, s1, v20
ds_read_b128 v[192:195], v20 offset:2048
ds_read_b128 v[196:199], v20 offset:3072
s_waitcnt lgkmcnt(0)
v_readfirstlane_b32 s62, v240
s_nop 0
s_lshr_b32 s62, s62, 8
v_max3_f32 v241, v232, v233, v234
v_max_f32 v241, v241, v235
v_sub_f32 v232, v232, v241
v_sub_f32 v233, v233, v241
v_sub_f32 v234, v234, v241
v_sub_f32 v235, v235, v241
v_exp_f32 v232, v232
v_exp_f32 v233, v233
v_exp_f32 v234, v234
v_exp_f32 v235, v235
v_mul_f32 v242, v232, v236
v_fmac_f32 v242, v233, v237
v_fmac_f32 v242, v234, v238
v_fmac_f32 v242, v235, v239
v_lshlrev_b32 v23, 16, v16
v_lshl_add_u32 v23, v7, 13, v23
v_bfe_u32 v8, v1, 3, 1
v_lshl_add_u32 v23, v8, 5, v23
v_and_b32 v8, 2, v1
v_lshl_add_u32 v23, v8, 3, v23
v_and_b32 v8, 1, v1
v_lshl_add_u32 v23, v8, 6, v23
v_lshlrev_b32 v21, 2, v1
s_lshl_b32 s1, s3, 9
v_add_u32 v24, s1, v21
s_lshl_b32 s1, s3, 11
v_add_u32 v25, s1, v21
v_cndmask_b32 v200, 0, v192, s[64:65]
v_cndmask_b32 v201, 0, v193, s[64:65]
v_cndmask_b32 v202, 0, v194, s[64:65]
v_cndmask_b32 v203, 0, v195, s[64:65]
v_cndmask_b32 v204, 0, v192, s[66:67]
v_cndmask_b32 v205, 0, v193, s[66:67]
v_cndmask_b32 v206, 0, v194, s[66:67]
v_cndmask_b32 v207, 0, v195, s[66:67]
v_cndmask_b32 v208, 0, v192, s[68:69]
v_cndmask_b32 v209, 0, v193, s[68:69]
v_cndmask_b32 v210, 0, v194, s[68:69]
v_cndmask_b32 v211, 0, v195, s[68:69]
v_cndmask_b32 v212, 0, v192, s[70:71]
v_cndmask_b32 v213, 0, v193, s[70:71]
v_cndmask_b32 v214, 0, v194, s[70:71]
v_cndmask_b32 v215, 0, v195, s[70:71]
v_cndmask_b32 v216, 0, v192, s[72:73]
v_cndmask_b32 v217, 0, v193, s[72:73]
v_cndmask_b32 v218, 0, v194, s[72:73]
v_cndmask_b32 v219, 0, v195, s[72:73]
v_cndmask_b32 v220, 0, v192, s[74:75]
v_cndmask_b32 v221, 0, v193, s[74:75]
v_cndmask_b32 v222, 0, v194, s[74:75]
v_cndmask_b32 v223, 0, v195, s[74:75]
v_cndmask_b32 v224, 0, v192, s[76:77]
v_cndmask_b32 v225, 0, v193, s[76:77]
v_cndmask_b32 v226, 0, v194, s[76:77]
v_cndmask_b32 v227, 0, v195, s[76:77]
v_cndmask_b32 v228, 0, v192, s[78:79]
v_cndmask_b32 v229, 0, v193, s[78:79]
v_cndmask_b32 v230, 0, v194, s[78:79]
v_cndmask_b32 v231, 0, v195, s[78:79]
s_waitcnt vmcnt(24)
v_perm_b32 v36, v68, v64, s60
v_perm_b32 v37, v76, v72, s60
v_perm_b32 v38, v84, v80, s60
v_perm_b32 v39, v92, v88, s60
v_perm_b32 v40, v68, v64, s61
v_perm_b32 v41, v76, v72, s61
v_perm_b32 v42, v84, v80, s61
v_perm_b32 v43, v92, v88, s61
v_mfma_f32_16x16x32_bf16 v[244:247], v[36:39], v[200:203], 0
s_nop 0
v_mfma_f32_16x16x32_bf16 v[244:247], v[40:43], v[204:207], v[244:247]
v_perm_b32 v44, v69, v65, s60
v_perm_b32 v45, v77, v73, s60
v_perm_b32 v46, v85, v81, s60
v_perm_b32 v47, v93, v89, s60
v_perm_b32 v48, v69, v65, s61
v_perm_b32 v49, v77, v73, s61
v_perm_b32 v50, v85, v81, s61
v_perm_b32 v51, v93, v89, s61
v_mfma_f32_16x16x32_bf16 v[244:247], v[44:47], v[208:211], v[244:247]
s_nop 0
v_mfma_f32_16x16x32_bf16 v[244:247], v[48:51], v[212:215], v[244:247]
v_perm_b32 v36, v70, v66, s60
v_perm_b32 v37, v78, v74, s60
v_perm_b32 v38, v86, v82, s60
v_perm_b32 v39, v94, v90, s60
v_perm_b32 v40, v70, v66, s61
v_perm_b32 v41, v78, v74, s61
v_perm_b32 v42, v86, v82, s61
v_perm_b32 v43, v94, v90, s61
v_mfma_f32_16x16x32_bf16 v[244:247], v[36:39], v[216:219], v[244:247]
s_nop 0
v_mfma_f32_16x16x32_bf16 v[244:247], v[40:43], v[220:223], v[244:247]
v_perm_b32 v44, v71, v67, s60
v_perm_b32 v45, v79, v75, s60
v_perm_b32 v46, v87, v83, s60
v_perm_b32 v47, v95, v91, s60
v_perm_b32 v48, v71, v67, s61
v_perm_b32 v49, v79, v75, s61
v_perm_b32 v50, v87, v83, s61
v_perm_b32 v51, v95, v91, s61
v_mfma_f32_16x16x32_bf16 v[244:247], v[44:47], v[224:227], v[244:247]
s_nop 0
v_mfma_f32_16x16x32_bf16 v[244:247], v[48:51], v[228:231], v[244:247]
s_waitcnt vmcnt(16)
v_perm_b32 v36, v100, v96, s60
v_perm_b32 v37, v108, v104, s60
v_perm_b32 v38, v116, v112, s60
v_perm_b32 v39, v124, v120, s60
v_perm_b32 v40, v100, v96, s61
v_perm_b32 v41, v108, v104, s61
v_perm_b32 v42, v116, v112, s61
v_perm_b32 v43, v124, v120, s61
v_mfma_f32_16x16x32_bf16 v[248:251], v[36:39], v[200:203], 0
s_nop 0
v_mfma_f32_16x16x32_bf16 v[248:251], v[40:43], v[204:207], v[248:251]
v_perm_b32 v44, v101, v97, s60
v_perm_b32 v45, v109, v105, s60
v_perm_b32 v46, v117, v113, s60
v_perm_b32 v47, v125, v121, s60
v_perm_b32 v48, v101, v97, s61
v_perm_b32 v49, v109, v105, s61
v_perm_b32 v50, v117, v113, s61
v_perm_b32 v51, v125, v121, s61
v_mfma_f32_16x16x32_bf16 v[248:251], v[44:47], v[208:211], v[248:251]
s_nop 0
v_mfma_f32_16x16x32_bf16 v[248:251], v[48:51], v[212:215], v[248:251]
v_perm_b32 v36, v102, v98, s60
v_perm_b32 v37, v110, v106, s60
v_perm_b32 v38, v118, v114, s60
v_perm_b32 v39, v126, v122, s60
v_perm_b32 v40, v102, v98, s61
v_perm_b32 v41, v110, v106, s61
v_perm_b32 v42, v118, v114, s61
v_perm_b32 v43, v126, v122, s61
v_mfma_f32_16x16x32_bf16 v[248:251], v[36:39], v[216:219], v[248:251]
s_nop 0
v_mfma_f32_16x16x32_bf16 v[248:251], v[40:43], v[220:223], v[248:251]
v_perm_b32 v44, v103, v99, s60
v_perm_b32 v45, v111, v107, s60
v_perm_b32 v46, v119, v115, s60
v_perm_b32 v47, v127, v123, s60
v_perm_b32 v48, v103, v99, s61
v_perm_b32 v49, v111, v107, s61
v_perm_b32 v50, v119, v115, s61
v_perm_b32 v51, v127, v123, s61
v_mfma_f32_16x16x32_bf16 v[248:251], v[44:47], v[224:227], v[248:251]
s_nop 0
v_mfma_f32_16x16x32_bf16 v[248:251], v[48:51], v[228:231], v[248:251]
v_cndmask_b32 v200, 0, v196, s[64:65]
v_cndmask_b32 v201, 0, v197, s[64:65]
v_cndmask_b32 v202, 0, v198, s[64:65]
v_cndmask_b32 v203, 0, v199, s[64:65]
v_cndmask_b32 v204, 0, v196, s[66:67]
v_cndmask_b32 v205, 0, v197, s[66:67]
v_cndmask_b32 v206, 0, v198, s[66:67]
v_cndmask_b32 v207, 0, v199, s[66:67]
v_cndmask_b32 v208, 0, v196, s[68:69]
v_cndmask_b32 v209, 0, v197, s[68:69]
v_cndmask_b32 v210, 0, v198, s[68:69]
v_cndmask_b32 v211, 0, v199, s[68:69]
v_cndmask_b32 v212, 0, v196, s[70:71]
v_cndmask_b32 v213, 0, v197, s[70:71]
v_cndmask_b32 v214, 0, v198, s[70:71]
v_cndmask_b32 v215, 0, v199, s[70:71]
v_cndmask_b32 v216, 0, v196, s[72:73]
v_cndmask_b32 v217, 0, v197, s[72:73]
v_cndmask_b32 v218, 0, v198, s[72:73]
v_cndmask_b32 v219, 0, v199, s[72:73]
v_cndmask_b32 v220, 0, v196, s[74:75]
v_cndmask_b32 v221, 0, v197, s[74:75]
v_cndmask_b32 v222, 0, v198, s[74:75]
v_cndmask_b32 v223, 0, v199, s[74:75]
v_cndmask_b32 v224, 0, v196, s[76:77]
v_cndmask_b32 v225, 0, v197, s[76:77]
v_cndmask_b32 v226, 0, v198, s[76:77]
v_cndmask_b32 v227, 0, v199, s[76:77]
v_cndmask_b32 v228, 0, v196, s[78:79]
v_cndmask_b32 v229, 0, v197, s[78:79]
v_cndmask_b32 v230, 0, v198, s[78:79]
v_cndmask_b32 v231, 0, v199, s[78:79]
s_waitcnt vmcnt(8)
v_perm_b32 v36, v132, v128, s60
v_perm_b32 v37, v140, v136, s60
v_perm_b32 v38, v148, v144, s60
v_perm_b32 v39, v156, v152, s60
v_perm_b32 v40, v132, v128, s61
v_perm_b32 v41, v140, v136, s61
v_perm_b32 v42, v148, v144, s61
v_perm_b32 v43, v156, v152, s61
v_mfma_f32_16x16x32_bf16 v[244:247], v[36:39], v[200:203], v[244:247]
s_nop 0
v_mfma_f32_16x16x32_bf16 v[244:247], v[40:43], v[204:207], v[244:247]
v_perm_b32 v44, v133, v129, s60
v_perm_b32 v45, v141, v137, s60
v_perm_b32 v46, v149, v145, s60
v_perm_b32 v47, v157, v153, s60
v_perm_b32 v48, v133, v129, s61
v_perm_b32 v49, v141, v137, s61
v_perm_b32 v50, v149, v145, s61
v_perm_b32 v51, v157, v153, s61
v_mfma_f32_16x16x32_bf16 v[244:247], v[44:47], v[208:211], v[244:247]
s_nop 0
v_mfma_f32_16x16x32_bf16 v[244:247], v[48:51], v[212:215], v[244:247]
v_perm_b32 v36, v134, v130, s60
v_perm_b32 v37, v142, v138, s60
v_perm_b32 v38, v150, v146, s60
v_perm_b32 v39, v158, v154, s60
v_perm_b32 v40, v134, v130, s61
v_perm_b32 v41, v142, v138, s61
v_perm_b32 v42, v150, v146, s61
v_perm_b32 v43, v158, v154, s61
v_mfma_f32_16x16x32_bf16 v[244:247], v[36:39], v[216:219], v[244:247]
s_nop 0
v_mfma_f32_16x16x32_bf16 v[244:247], v[40:43], v[220:223], v[244:247]
v_perm_b32 v44, v135, v131, s60
v_perm_b32 v45, v143, v139, s60
v_perm_b32 v46, v151, v147, s60
v_perm_b32 v47, v159, v155, s60
v_perm_b32 v48, v135, v131, s61
v_perm_b32 v49, v143, v139, s61
v_perm_b32 v50, v151, v147, s61
v_perm_b32 v51, v159, v155, s61
v_mfma_f32_16x16x32_bf16 v[244:247], v[44:47], v[224:227], v[244:247]
s_nop 0
v_mfma_f32_16x16x32_bf16 v[244:247], v[48:51], v[228:231], v[244:247]
s_nop 7
ds_write_b32 v25, v244 offset:10240
ds_write_b32 v25, v245 offset:10496
ds_write_b32 v25, v246 offset:10752
ds_write_b32 v25, v247 offset:11008
s_lshl_b32 s0, s48, 17
s_lshl_b32 s1, s49, 7
s_add_u32 s0, s0, s1
s_add_u32 s0, s0, 1048576
s_bfe_u32 s1, s3, 0x10001
s_lshl_b32 s1, s1, 15
s_add_u32 s0, s0, s1
s_and_b32 s1, s3, 1
s_lshl_b32 s1, s1, 12
s_add_u32 s0, s0, s1
v_mov_b32 v197, s51
v_mov_b32 v199, s51
s_waitcnt vmcnt(0)
v_perm_b32 v36, v164, v160, s60
v_perm_b32 v37, v172, v168, s60
v_perm_b32 v38, v180, v176, s60
v_perm_b32 v39, v188, v184, s60
v_perm_b32 v40, v164, v160, s61
v_perm_b32 v41, v172, v168, s61
v_perm_b32 v42, v180, v176, s61
v_perm_b32 v43, v188, v184, s61
v_mfma_f32_16x16x32_bf16 v[248:251], v[36:39], v[200:203], v[248:251]
s_nop 0
v_mfma_f32_16x16x32_bf16 v[248:251], v[40:43], v[204:207], v[248:251]
v_perm_b32 v44, v165, v161, s60
v_perm_b32 v45, v173, v169, s60
v_perm_b32 v46, v181, v177, s60
v_perm_b32 v47, v189, v185, s60
v_perm_b32 v48, v165, v161, s61
v_perm_b32 v49, v173, v169, s61
v_perm_b32 v50, v181, v177, s61
v_perm_b32 v51, v189, v185, s61
v_mfma_f32_16x16x32_bf16 v[248:251], v[44:47], v[208:211], v[248:251]
s_nop 0
v_mfma_f32_16x16x32_bf16 v[248:251], v[48:51], v[212:215], v[248:251]
v_perm_b32 v36, v166, v162, s60
v_perm_b32 v37, v174, v170, s60
v_perm_b32 v38, v182, v178, s60
v_perm_b32 v39, v190, v186, s60
v_perm_b32 v40, v166, v162, s61
v_perm_b32 v41, v174, v170, s61
v_perm_b32 v42, v182, v178, s61
v_perm_b32 v43, v190, v186, s61
v_mfma_f32_16x16x32_bf16 v[248:251], v[36:39], v[216:219], v[248:251]
s_nop 0
v_mfma_f32_16x16x32_bf16 v[248:251], v[40:43], v[220:223], v[248:251]
v_perm_b32 v44, v167, v163, s60
v_perm_b32 v45, v175, v171, s60
v_perm_b32 v46, v183, v179, s60
v_perm_b32 v47, v191, v187, s60
v_perm_b32 v48, v167, v163, s61
v_perm_b32 v49, v175, v171, s61
v_perm_b32 v50, v183, v179, s61
v_perm_b32 v51, v191, v187, s61
v_mfma_f32_16x16x32_bf16 v[248:251], v[44:47], v[224:227], v[248:251]
s_nop 0
v_mfma_f32_16x16x32_bf16 v[248:251], v[48:51], v[228:231], v[248:251]
s_mov_b32 s64, 0x55555555
s_mov_b32 s65, 0x55555555
s_nop 5
ds_write_b32 v25, v248 offset:11264
ds_write_b32 v25, v249 offset:11520
ds_write_b32 v25, v250 offset:11776
ds_write_b32 v25, v251 offset:12032
s_waitcnt lgkmcnt(0)
s_barrier
ds_read_b32 v192, v24 offset:10240
ds_read_b32 v193, v24 offset:12288
ds_read_b32 v194, v24 offset:14336
ds_read_b32 v195, v24 offset:16384
ds_read_b32 v200, v24 offset:10496
ds_read_b32 v201, v24 offset:12544
ds_read_b32 v202, v24 offset:14592
ds_read_b32 v203, v24 offset:16640
s_waitcnt lgkmcnt(0)
v_mul_f32 v252, v192, v232
v_mul_f32 v254, v200, v232
v_fmac_f32 v252, v193, v233
v_fmac_f32 v254, v201, v233
v_fmac_f32 v252, v194, v234
v_fmac_f32 v254, v202, v234
v_fmac_f32 v252, v195, v235
v_fmac_f32 v254, v203, v235
s_nop 0
v_mov_b32_dpp v192, v252 quad_perm:[1,0,3,2] row_mask:0xf bank_mask:0xf
v_mov_b32_dpp v193, v254 quad_perm:[1,0,3,2] row_mask:0xf bank_mask:0xf
v_cndmask_b32 v196, v193, v252, s[64:65]
v_cndmask_b32 v198, v254, v192, s[64:65]
s_cmp_lg_u32 s62, 0
s_cbranch_scc1 L_s5a
buffer_store_dwordx4 v[196:199], v23, s[40:43], s0 offen
s_branch L_s5b
L_s5a:
buffer_store_dwordx4 v[196:199], v23, s[40:43], s0 offen sc1
L_s5b:
L_nob:
v_lshrrev_b32 v20, 5, v1
v_mul_u32_u24 v20, 7168, v20
v_and_b32 v8, 31, v1
v_lshl_add_u32 v20, v8, 2, v20
s_lshl_b32 s1, s3, 7
v_add_u32 v20, s1, v20
s_cmp_eq_u32 s3, 7
s_cbranch_scc1 L_nowr
s_mov_b32 s100, 1000000
L_w6:
ds_read_b32 v21, v22 offset:12
s_waitcnt lgkmcnt(0)
v_readfirstlane_b32 s0, v21
s_sub_u32 s100, s100, 1
s_cmp_eq_u32 s100, 0
s_cbranch_scc1 L_w6x
s_cmp_lt_u32 s0, 4
s_cbranch_scc1 L_w6
L_w6x:
ds_read_b32 v28, v20 offset:19456
ds_read_b32 v29, v20 offset:20352
ds_read_b32 v30, v20 offset:21248
ds_read_b32 v31, v20 offset:22144
ds_read_b32 v32, v20 offset:23040
ds_read_b32 v33, v20 offset:23936
ds_read_b32 v34, v20 offset:24832
ds_read_b32 v35, v20 offset:25728
v_lshrrev_b32 v27, 3, v1
v_lshlrev_b32 v27, 12, v27
v_and_b32 v9, 7, v1
v_lshl_add_u32 v27, v9, 4, v27
s_mul_i32 s0, s48, 114688
s_lshl_b32 s1, s3, 14
s_add_u32 s0, s0, s1
s_lshl_b32 s1, s49, 7
s_add_u32 s0, s0, s1
s_add_u32 s0, s0, 2097152
v_mov_b32 v105, s51
v_mov_b32 v107, s51
s_waitcnt lgkmcnt(0)
v_lshlrev_b32 v36, 16, v28
v_and_b32 v37, 0xffff0000, v28
v_lshlrev_b32 v38, 16, v29
v_and_b32 v39, 0xffff0000, v29
v_lshlrev_b32 v40, 16, v30
v_and_b32 v41, 0xffff0000, v30
v_lshlrev_b32 v42, 16, v31
v_and_b32 v43, 0xffff0000, v31
v_lshlrev_b32 v44, 16, v32
v_and_b32 v45, 0xffff0000, v32
v_lshlrev_b32 v46, 16, v33
v_and_b32 v47, 0xffff0000, v33
v_lshlrev_b32 v48, 16, v34
v_and_b32 v49, 0xffff0000, v34
v_lshlrev_b32 v50, 16, v35
v_and_b32 v51, 0xffff0000, v35
L_nowr:
v_lshrrev_b32 v8, 5, v1
v_lshlrev_b32 v8, 5, v8
s_mul_i32 s60, s48, 114688
s_lshl_b32 s1, s49, 12
s_add_u32 s60, s60, s1
s_add_u32 s60, s60, 2097152
v_lshlrev_b32 v14, 4, v1
s_waitcnt lgkmcnt(0)
s_barrier
s_cmp_eq_u32 s3, 7
s_cbranch_scc1 L_stageC
ds_read_b128 v[96:99], v8 offset:1216
ds_read_b128 v[100:103], v8 offset:1232
s_waitcnt lgkmcnt(1)
v_mul_f32 v104, v96, v36
v_mul_f32 v106, v96, v37
v_mul_f32 v108, v97, v38
v_mul_f32 v109, v97, v39
v_fmac_f32 v104, v98, v40
v_fmac_f32 v106, v98, v41
v_fmac_f32 v108, v99, v42
v_fmac_f32 v109, v99, v43
s_waitcnt lgkmcnt(0)
v_fmac_f32 v104, v100, v44
v_fmac_f32 v106, v100, v45
v_fmac_f32 v108, v101, v46
v_fmac_f32 v109, v101, v47
v_fmac_f32 v104, v102, v48
v_fmac_f32 v106, v102, v49
v_fmac_f32 v108, v103, v50
v_fmac_f32 v109, v103, v51
v_add_f32 v104, v104, v108
v_add_f32 v106, v106, v109
v_mov_b32 v108, v104
v_mov_b32 v109, v106
s_nop 0
v_permlane32_swap_b32 v108, v104
v_permlane32_swap_b32 v109, v106
v_add_f32 v104, v104, v108
v_add_f32 v106, v106, v109
s_mov_b32 exec_hi, 0
s_cmp_lg_u32 s62, 0
s_cbranch_scc1 L_s7a
buffer_store_dwordx4 v[104:107], v27, s[40:43], s0 offen
s_branch L_s7b
L_s7a:
buffer_store_dwordx4 v[104:107], v27, s[40:43], s0 offen sc1
L_s7b:
s_branch L_end
L_stageC:
s_cmp_ge_u32 s49, 28
s_cbranch_scc1 L_end
s_mov_b32 s100, 1000000
s_lshl_b32 s61, s49, 10
s_add_u32 s61, s61, 3145728
s_lshl_b32 s1, s48, 7
s_add_u32 s1, s1, s61
v_mov_b32 v105, s51
v_mov_b32 v107, s51
buffer_load_dwordx4 v[128:131], v14, s[40:43], s60 offen offset:0 sc1
buffer_load_dwordx4 v[132:135], v14, s[40:43], s60 offen offset:1024 sc1
buffer_load_dwordx4 v[136:139], v14, s[40:43], s60 offen offset:2048 sc1
buffer_load_dwordx4 v[140:143], v14, s[40:43], s60 offen offset:3072 sc1
L_cpoll:
buffer_load_dwordx4 v[164:167], v14, s[40:43], s60 offen offset:0 sc1
buffer_load_dwordx4 v[168:171], v14, s[40:43], s60 offen offset:1024 sc1
buffer_load_dwordx4 v[172:175], v14, s[40:43], s60 offen offset:2048 sc1
buffer_load_dwordx4 v[176:179], v14, s[40:43], s60 offen offset:3072 sc1
s_waitcnt vmcnt(4)
v_min3_u32 v96, v129, v131, v133
v_max3_u32 v97, v129, v131, v133
v_add_f32 v104, v128, v132
v_add_f32 v106, v130, v134
v_min3_u32 v96, v96, v135, v137
v_max3_u32 v97, v97, v135, v137
v_add_f32 v108, v136, v140
v_add_f32 v109, v138, v142
v_min3_u32 v96, v96, v139, v141
v_max3_u32 v97, v97, v139, v141
v_add_f32 v104, v104, v108
v_add_f32 v106, v106, v109
v_min_u32 v96, v96, v143
v_max_u32 v97, v97, v143
v_xor_b32 v96, s51, v96
v_xor_b32 v97, s51, v97
v_or_b32 v96, v96, v97
v_add_f32_dpp v104, v104, v104 row_ror:8 row_mask:0xf bank_mask:0xf
v_add_f32_dpp v106, v106, v106 row_ror:8 row_mask:0xf bank_mask:0xf
v_cmp_ne_u32 vcc, 0, v96
s_cbranch_vccz L_cok
buffer_load_dwordx4 v[128:131], v14, s[40:43], s60 offen offset:0 sc1
buffer_load_dwordx4 v[132:135], v14, s[40:43], s60 offen offset:1024 sc1
buffer_load_dwordx4 v[136:139], v14, s[40:43], s60 offen offset:2048 sc1
buffer_load_dwordx4 v[140:143], v14, s[40:43], s60 offen offset:3072 sc1
s_waitcnt vmcnt(4)
v_min3_u32 v96, v165, v167, v169
v_max3_u32 v97, v165, v167, v169
v_add_f32 v104, v164, v168
v_add_f32 v106, v166, v170
v_min3_u32 v96, v96, v171, v173
v_max3_u32 v97, v97, v171, v173
v_add_f32 v108, v172, v176
v_add_f32 v109, v174, v178
v_min3_u32 v96, v96, v175, v177
v_max3_u32 v97, v97, v175, v177
v_add_f32 v104, v104, v108
v_add_f32 v106, v106, v109
v_min_u32 v96, v96, v179
v_max_u32 v97, v97, v179
v_xor_b32 v96, s51, v96
v_xor_b32 v97, s51, v97
v_or_b32 v96, v96, v97
v_add_f32_dpp v104, v104, v104 row_ror:8 row_mask:0xf bank_mask:0xf
v_add_f32_dpp v106, v106, v106 row_ror:8 row_mask:0xf bank_mask:0xf
v_cmp_ne_u32 vcc, 0, v96
s_cbranch_vccz L_cok
s_sub_u32 s100, s100, 1
s_cmp_lg_u32 s100, 0
s_cbranch_scc1 L_cpoll
L_cok:
v_mov_b32 v96, v104
v_mov_b32 v97, v106
s_nop 0
v_permlane16_swap_b32 v96, v104
v_permlane16_swap_b32 v97, v106
v_add_f32 v104, v104, v96
v_add_f32 v106, v106, v97
v_mov_b32 v96, v104
v_mov_b32 v97, v106
s_nop 0
v_permlane32_swap_b32 v96, v104
v_permlane32_swap_b32 v97, v106
v_add_f32 v104, v104, v96
v_add_f32 v106, v106, v97
s_mov_b32 exec_lo, 0xff
s_mov_b32 exec_hi, 0
buffer_store_dwordx4 v[104:107], v14, s[40:43], s1 offen sc1
s_mov_b64 exec, -1
s_and_b32 s1, s49, 7
s_cmp_lg_u32 s1, s48
s_cbranch_scc1 L_end
s_mov_b32 s100, 1000000
buffer_load_dwordx4 v[180:183], v14, s[40:43], s61 offen sc1
L_dpoll:
buffer_load_dwordx4 v[184:187], v14, s[40:43], s61 offen sc1
s_waitcnt vmcnt(1)
v_xor_b32 v96, s51, v181
v_xor_b32 v97, s51, v183
v_or_b32 v96, v96, v97
v_add_f32_dpp v112, v180, v180 row_ror:8 row_mask:0xf bank_mask:0xf
v_add_f32_dpp v113, v182, v182 row_ror:8 row_mask:0xf bank_mask:0xf
v_cmp_ne_u32 vcc, 0, v96
s_cbranch_vccz L_dok
buffer_load_dwordx4 v[180:183], v14, s[40:43], s61 offen sc1
s_waitcnt vmcnt(1)
v_xor_b32 v96, s51, v185
v_xor_b32 v97, s51, v187
v_or_b32 v96, v96, v97
v_add_f32_dpp v112, v184, v184 row_ror:8 row_mask:0xf bank_mask:0xf
v_add_f32_dpp v113, v186, v186 row_ror:8 row_mask:0xf bank_mask:0xf
v_cmp_ne_u32 vcc, 0, v96
s_cbranch_vccz L_dok
s_sub_u32 s100, s100, 1
s_cmp_lg_u32 s100, 0
s_cbranch_scc1 L_dpoll
L_dok:
v_mov_b32 v96, v112
v_mov_b32 v97, v113
s_nop 0
v_permlane16_swap_b32 v96, v112
v_permlane16_swap_b32 v97, v113
v_add_f32 v112, v112, v96
v_add_f32 v113, v113, v97
v_mov_b32 v96, v112
v_mov_b32 v97, v113
s_nop 0
v_permlane32_swap_b32 v96, v112
v_permlane32_swap_b32 v97, v113
v_add_f32 v112, v112, v96
v_add_f32 v113, v113, v97
v_cvt_pk_bf16_f32 v98, v112, v113
s_lshl_b32 s1, s49, 5
v_lshlrev_b32 v99, 2, v1
s_mov_b32 exec_lo, 0xff
s_mov_b32 exec_hi, 0
buffer_store_dword v98, v99, s[44:47], s1 offen
s_cmp_lg_u32 s49, 0
s_cbranch_scc1 L_end
s_mov_b32 exec_lo, 1
v_mov_b32 v100, s50
v_mov_b32 v101, 0
buffer_store_dword v100, v101, s[40:43], 0 offen sc1
L_end:
L_done:
s_endpgm
.section .rodata,"a"
.p2align 6
.amdhsa_kernel standalone__gqa_block_cached__decode_kernel
  .amdhsa_next_free_vgpr 256
  .amdhsa_next_free_sgpr 102
  .amdhsa_accum_offset 256
  .amdhsa_group_segment_fixed_size 0
  .amdhsa_kernarg_size 64
  .amdhsa_user_sgpr_count 2
  .amdhsa_user_sgpr_kernarg_segment_ptr 1
  .amdhsa_system_sgpr_workgroup_id_x 1
.end_amdhsa_kernel
```
